```python
import torch

def _softmax(x, axis=-1):
    return torch.softmax(x, dim=axis)
def _gelu(x):
    return torch.nn.functional.gelu(x, approximate="tanh")
def _silu(x):
    return torch.nn.functional.silu(x)
def _sigmoid(x):
    return torch.sigmoid(x)
def _layernorm(x, axis=-1, eps=1e-5):
    m = x.mean(dim=axis, keepdim=True)
    v = x.var(dim=axis, keepdim=True, unbiased=False)
    return (x - m) / torch.sqrt(v + eps)
def _scatter_add(tgt, idx, src, axis=0):
    return tgt.clone().index_add_(axis, idx, src)
def _segment_sum(src, seg, n):
    out = torch.zeros((n,) + src.shape[1:], dtype=src.dtype)
    return out.index_add_(0, seg, src)
def _pad(x, pw):
    flat = tuple(v for pair in reversed(pw) for v in pair)
    return torch.nn.functional.pad(x, flat)

kernel_name = 'standalone__gqa_softmax__sampling'

def setup_inputs():

    _w = (lambda a: (lambda t: t.to(torch.bfloat16) if t.is_floating_point() else t)(torch.as_tensor(a)))
    B, Hq, Hkv, Sq, Sk, D = 16, 32, 8, 1, 4096, 128
    return {
        "q": _w((lambda *s: torch.randn(*s, dtype=torch.bfloat16) * 0.8)(B, Hq, Sq, D)),
        "k": _w((lambda *s: torch.randn(*s, dtype=torch.bfloat16) * 0.8)(B, Hkv, Sk, D)),
        "v": _w((lambda *s: torch.randn(*s, dtype=torch.bfloat16) * 0.05)(B, Hkv, Sk, D)),
    }

def reference(q, k, v):
    B, Hq, Sq, D = q.shape
    Hkv = k.shape[1]
    rep = Hq // Hkv
    k = (lambda x, n, axis: torch.repeat_interleave(x, n, dim=axis))(k, rep, axis=1)
    v = (lambda x, n, axis: torch.repeat_interleave(x, n, dim=axis))(v, rep, axis=1)
    scale = D ** -0.5
    scores = torch.einsum("bhqd,bhkd->bhqk", q, k) * scale
    p = _softmax(scores, axis=-1)
    return torch.einsum("bhqk,bhkd->bhqd", p, v)
```

```asm
; @launch grid=(256,1,1) block=(256,1,1) lds=8576
.amdgcn_target "amdgcn-amd-amdhsa--gfx950"
.text
.globl standalone__gqa_softmax__sampling_kernel
.p2align 8
.type standalone__gqa_softmax__sampling_kernel,@function
standalone__gqa_softmax__sampling_kernel:
  s_load_dwordx2 s[4:5], s[0:1], 8
  s_load_dwordx2 s[12:13], s[0:1], 0
  s_load_dwordx2 s[8:9], s[0:1], 16
  s_load_dwordx2 s[24:25], s[0:1], 40
  s_load_dwordx2 s[20:21], s[0:1], 32
  s_load_dwordx2 s[16:17], s[0:1], 24
  s_cmp_ge_u32 s2, 256
  s_cbranch_scc1 L_end
  v_lshrrev_b32 v5, 6, v0
  v_and_b32 v26, 63, v0
  v_readfirstlane_b32 s3, v5
  s_and_b32 s29, s2, 1
  s_mul_i32 s36, s29, 5
  s_xor_b32 s28, s2, s36
  s_lshr_b32 s28, s28, 1
  v_bfe_u32 v5, v26, 2, 2
  v_and_b32 v6, 48, v26
  v_and_b32 v7, 3, v26
  v_lshlrev_b32 v6, 2, v6
  v_lshl_add_u32 v1, v5, 8, v6
  v_lshl_add_u32 v1, v7, 4, v1
  v_lshl_add_u32 v24, v7, 8, v6
  v_lshl_add_u32 v24, v5, 4, v24
  v_mov_b32 v60, v1
  v_mov_b32 v61, v1
  s_mul_i32 s72, s29, 393216
  s_lshl_b32 s36, s3, 12
  s_add_u32 s72, s72, s36
  s_mov_b32 s73, s72
  s_add_u32 s68, s73, 0
  s_add_u32 s69, s73, 16384
  s_add_u32 s70, s73, 32768
  s_add_u32 s71, s73, 49152
  s_mov_b32 s62, 0x100000
  s_mov_b32 s63, 0x20000
  s_mov_b32 s66, 0x100000
  s_mov_b32 s67, 0x20000
  s_mov_b32 s14, 0x20000
  s_mov_b32 s15, 0x20000
  s_lshl_b32 s49, s28, 10
  s_lshl_b32 s36, s28, 20
  s_waitcnt lgkmcnt(0)
  s_add_u32 s4, s4, s36
  s_addc_u32 s5, s5, 0
  s_mov_b64 s[60:61], s[4:5]
  s_mov_b64 s[64:65], s[4:5]
  buffer_load_dwordx4 a[0:3], v60, s[60:63], s68 offen offset:0 nt
  buffer_load_dwordx4 a[4:7], v60, s[60:63], s68 offen offset:1024 nt
  buffer_load_dwordx4 a[8:11], v60, s[60:63], s68 offen offset:2048 nt
  buffer_load_dwordx4 a[12:15], v60, s[60:63], s68 offen offset:3072 nt
  buffer_load_dwordx4 v[8:11], v24, s[12:15], s49 offen
  s_add_u32 s8, s8, s36
  s_addc_u32 s9, s9, 0
  v_mov_b32 v27, 0
  v_lshlrev_b32 v3, 2, v26
  s_lshl_b32 s37, s3, 6
  s_add_u32 s37, s37, 8320
  v_add_u32 v3, s37, v3
  s_mov_b64 exec, 0xffff
  ds_write_b32 v3, v27
  s_mov_b64 exec, -1
  s_barrier
  buffer_load_dwordx4 a[16:19], v61, s[64:67], s69 offen offset:0 nt
  buffer_load_dwordx4 a[20:23], v61, s[64:67], s69 offen offset:1024 nt
  buffer_load_dwordx4 a[24:27], v61, s[64:67], s69 offen offset:2048 nt
  buffer_load_dwordx4 a[28:31], v61, s[64:67], s69 offen offset:3072 nt
  s_barrier
  buffer_load_dwordx4 a[32:35], v60, s[60:63], s70 offen offset:0 nt
  buffer_load_dwordx4 a[36:39], v60, s[60:63], s70 offen offset:1024 nt
  buffer_load_dwordx4 a[40:43], v60, s[60:63], s70 offen offset:2048 nt
  buffer_load_dwordx4 a[44:47], v60, s[60:63], s70 offen offset:3072 nt
  s_waitcnt lgkmcnt(0)
  s_barrier
  buffer_load_dwordx4 a[48:51], v61, s[64:67], s71 offen offset:0 nt
  buffer_load_dwordx4 a[52:55], v61, s[64:67], s71 offen offset:1024 nt
  buffer_load_dwordx4 a[56:59], v61, s[64:67], s71 offen offset:2048 nt
  buffer_load_dwordx4 a[60:63], v61, s[64:67], s71 offen offset:3072 nt
  v_lshlrev_b32 v2, 4, v26
  s_mov_b32 s6, 0x100000
  s_mov_b32 s7, 0x20000
  s_mov_b32 s10, 0x100000
  s_mov_b32 s11, 0x20000
  s_mov_b32 s18, 0x20000
  s_mov_b32 s19, 0x20000
  s_mov_b32 s22, 256
  s_mov_b32 s23, 0x20000
  s_mov_b32 s26, 0x20000000
  s_mov_b32 s27, 0x20000
  s_lshl_b32 s46, s28, 12
  s_mul_i32 s36, s28, 4352
  s_add_u32 s36, s36, 0x400000
  s_add_u32 s42, s24, s36
  s_addc_u32 s43, s25, 0
  s_and_b32 s36, s28, 63
  s_lshl_b32 s47, s36, 2
  s_lshr_b32 s36, s28, 6
  s_lshl_b32 s48, 1, s36
  s_add_u32 s44, s20, s47
  s_addc_u32 s45, s21, 0
  v_mov_b32 v3, 8320
  v_mov_b32 v4, 1
  s_xor_b32 s41, s29, 0
  s_or_b32 s41, s41, s3
  s_lshl_b32 s41, s41, 8
  s_cbranch_scc1 L_nosig
  s_mov_b32 s34, 16
  s_mov_b32 s35, 1
  s_atomic_swap s34, s[42:43], 0 glc
  s_atomic_add s35, s[42:43], 4 glc
L_nosig:
  s_mul_i32 s30, s29, 8
  s_add_u32 s30, s30, s3
  s_and_b32 s36, s30, 3
  s_andn2_b32 s37, s30, 3
  s_lshl1_add_u32 s36, s37, s36
  s_lshl_b32 s32, s36, 12
  s_add_u32 s32, s32, 786432
  s_cmp_eq_u32 s29, 0
  s_cselect_b32 s40, 2, 2
  s_mov_b32 s38, 0x3e0293ee
  s_mov_b32 s39, 0xbe0293ee
  s_mov_b32 s33, 0
  s_mov_b32 s51, 0
  v_mov_b32 v20, 0x7f61b1e6
  v_mov_b32 v21, 0
  v_mov_b32 v12, 0
  v_mov_b32 v16, 0
  v_mov_b32 v13, 0
  v_mov_b32 v17, 0
  v_mov_b32 v14, 0
  v_mov_b32 v18, 0
  v_mov_b32 v15, 0
  v_mov_b32 v19, 0
  v_mov_b32 v36, 0
  v_mov_b32 v37, 0
  v_mov_b32 v38, 0
  v_mov_b32 v39, 0
  v_mov_b32 v40, 0
  v_mov_b32 v41, 0
  v_mov_b32 v42, 0
  v_mov_b32 v43, 0
  s_mov_b32 s74, 6
L_kl:
  s_add_u32 s73, s73, 0x10000
  s_cmp_lg_u32 s74, 1
  s_cbranch_scc1 L_kl1
  s_mov_b32 s73, s72
  s_mov_b64 s[60:61], s[8:9]
  s_mov_b64 s[64:65], s[8:9]
  v_mov_b32 v60, v2
  v_mov_b32 v61, v2
L_kl1:
  s_add_u32 s36, s41, s74
  s_cmp_lg_u32 s36, 4
  s_cbranch_scc1 L_kl2
  s_mov_b32 s36, s48
  s_waitcnt lgkmcnt(0)
  s_atomic_or s36, s[44:45], 0
L_kl2:
  s_add_u32 s68, s73, 0
  s_add_u32 s69, s73, 16384
  s_add_u32 s70, s73, 32768
  s_add_u32 s71, s73, 49152
  s_waitcnt vmcnt(12)
  v_mfma_f32_16x16x32_bf16 v[44:47], a[0:3], v[8:11], 0
  v_mfma_f32_16x16x32_bf16 v[48:51], a[4:7], v[8:11], 0
  v_mfma_f32_16x16x32_bf16 v[52:55], a[8:11], v[8:11], 0
  v_mfma_f32_16x16x32_bf16 v[56:59], a[12:15], v[8:11], 0
  s_barrier
  buffer_load_dwordx4 a[0:3], v60, s[60:63], s68 offen offset:0 nt
  buffer_load_dwordx4 a[4:7], v60, s[60:63], s68 offen offset:1024 nt
  buffer_load_dwordx4 a[8:11], v60, s[60:63], s68 offen offset:2048 nt
  buffer_load_dwordx4 a[12:15], v60, s[60:63], s68 offen offset:3072 nt
  v_mov_b32 v64, v68
  v_mov_b32 v65, v69
  v_mov_b32 v66, v70
  v_mov_b32 v67, v71
  v_mov_b32 v68, v72
  v_mov_b32 v69, v73
  v_mov_b32 v70, v74
  v_mov_b32 v71, v75
  v_mov_b32 v72, v76
  v_mov_b32 v73, v77
  v_mov_b32 v74, v78
  v_mov_b32 v75, v79
  v_mov_b32 v76, v80
  v_mov_b32 v77, v81
  v_mov_b32 v78, v82
  v_mov_b32 v79, v83
  v_mov_b32 v80, v84
  v_mov_b32 v81, v85
  v_mov_b32 v82, v86
  v_mov_b32 v83, v87
  v_add_f32_dpp v44, v45, v44 row_ror:12 row_mask:0xf bank_mask:0xf
  v_add_f32_dpp v46, v47, v46 row_ror:12 row_mask:0xf bank_mask:0xf
  v_add_f32_dpp v49, v50, v49 row_ror:12 row_mask:0xf bank_mask:0xf
  v_add_f32_dpp v51, v48, v51 row_ror:12 row_mask:0xf bank_mask:0xf
  v_add_f32_dpp v54, v55, v54 row_ror:12 row_mask:0xf bank_mask:0xf
  v_add_f32_dpp v52, v53, v52 row_ror:12 row_mask:0xf bank_mask:0xf
  v_add_f32_dpp v59, v56, v59 row_ror:12 row_mask:0xf bank_mask:0xf
  v_add_f32_dpp v57, v58, v57 row_ror:12 row_mask:0xf bank_mask:0xf
  v_add_f32_dpp v84, v46, v44 row_ror:8 row_mask:0xf bank_mask:0x1
  s_nop 1
  v_add_f32_dpp v84, v51, v49 row_ror:8 row_mask:0xf bank_mask:0x2
  s_nop 1
  v_add_f32_dpp v84, v52, v54 row_ror:8 row_mask:0xf bank_mask:0x4
  s_nop 1
  v_add_f32_dpp v84, v57, v59 row_ror:8 row_mask:0xf bank_mask:0x8
  s_waitcnt vmcnt(12)
  v_mfma_f32_16x16x32_bf16 v[44:47], a[16:19], v[8:11], 0
  v_mfma_f32_16x16x32_bf16 v[48:51], a[20:23], v[8:11], 0
  v_mfma_f32_16x16x32_bf16 v[52:55], a[24:27], v[8:11], 0
  v_mfma_f32_16x16x32_bf16 v[56:59], a[28:31], v[8:11], 0
  s_barrier
  buffer_load_dwordx4 a[16:19], v61, s[64:67], s69 offen offset:0 nt
  buffer_load_dwordx4 a[20:23], v61, s[64:67], s69 offen offset:1024 nt
  buffer_load_dwordx4 a[24:27], v61, s[64:67], s69 offen offset:2048 nt
  buffer_load_dwordx4 a[28:31], v61, s[64:67], s69 offen offset:3072 nt
  v_add_f32_dpp v44, v45, v44 row_ror:12 row_mask:0xf bank_mask:0xf
  v_add_f32_dpp v46, v47, v46 row_ror:12 row_mask:0xf bank_mask:0xf
  v_add_f32_dpp v49, v50, v49 row_ror:12 row_mask:0xf bank_mask:0xf
  v_add_f32_dpp v51, v48, v51 row_ror:12 row_mask:0xf bank_mask:0xf
  v_add_f32_dpp v54, v55, v54 row_ror:12 row_mask:0xf bank_mask:0xf
  v_add_f32_dpp v52, v53, v52 row_ror:12 row_mask:0xf bank_mask:0xf
  v_add_f32_dpp v59, v56, v59 row_ror:12 row_mask:0xf bank_mask:0xf
  v_add_f32_dpp v57, v58, v57 row_ror:12 row_mask:0xf bank_mask:0xf
  v_add_f32_dpp v85, v46, v44 row_ror:8 row_mask:0xf bank_mask:0x1
  s_nop 1
  v_add_f32_dpp v85, v51, v49 row_ror:8 row_mask:0xf bank_mask:0x2
  s_nop 1
  v_add_f32_dpp v85, v52, v54 row_ror:8 row_mask:0xf bank_mask:0x4
  s_nop 1
  v_add_f32_dpp v85, v57, v59 row_ror:8 row_mask:0xf bank_mask:0x8
  s_waitcnt vmcnt(12)
  v_mfma_f32_16x16x32_bf16 v[44:47], a[32:35], v[8:11], 0
  v_mfma_f32_16x16x32_bf16 v[48:51], a[36:39], v[8:11], 0
  v_mfma_f32_16x16x32_bf16 v[52:55], a[40:43], v[8:11], 0
  v_mfma_f32_16x16x32_bf16 v[56:59], a[44:47], v[8:11], 0
  s_barrier
  buffer_load_dwordx4 a[32:35], v60, s[60:63], s70 offen offset:0 nt
  buffer_load_dwordx4 a[36:39], v60, s[60:63], s70 offen offset:1024 nt
  buffer_load_dwordx4 a[40:43], v60, s[60:63], s70 offen offset:2048 nt
  buffer_load_dwordx4 a[44:47], v60, s[60:63], s70 offen offset:3072 nt
  v_add_f32_dpp v44, v45, v44 row_ror:12 row_mask:0xf bank_mask:0xf
  v_add_f32_dpp v46, v47, v46 row_ror:12 row_mask:0xf bank_mask:0xf
  v_add_f32_dpp v49, v50, v49 row_ror:12 row_mask:0xf bank_mask:0xf
  v_add_f32_dpp v51, v48, v51 row_ror:12 row_mask:0xf bank_mask:0xf
  v_add_f32_dpp v54, v55, v54 row_ror:12 row_mask:0xf bank_mask:0xf
  v_add_f32_dpp v52, v53, v52 row_ror:12 row_mask:0xf bank_mask:0xf
  v_add_f32_dpp v59, v56, v59 row_ror:12 row_mask:0xf bank_mask:0xf
  v_add_f32_dpp v57, v58, v57 row_ror:12 row_mask:0xf bank_mask:0xf
  v_add_f32_dpp v86, v46, v44 row_ror:8 row_mask:0xf bank_mask:0x1
  s_nop 1
  v_add_f32_dpp v86, v51, v49 row_ror:8 row_mask:0xf bank_mask:0x2
  s_nop 1
  v_add_f32_dpp v86, v52, v54 row_ror:8 row_mask:0xf bank_mask:0x4
  s_nop 1
  v_add_f32_dpp v86, v57, v59 row_ror:8 row_mask:0xf bank_mask:0x8
  s_waitcnt vmcnt(12)
  v_mfma_f32_16x16x32_bf16 v[44:47], a[48:51], v[8:11], 0
  v_mfma_f32_16x16x32_bf16 v[48:51], a[52:55], v[8:11], 0
  v_mfma_f32_16x16x32_bf16 v[52:55], a[56:59], v[8:11], 0
  v_mfma_f32_16x16x32_bf16 v[56:59], a[60:63], v[8:11], 0
  s_barrier
  buffer_load_dwordx4 a[48:51], v61, s[64:67], s71 offen offset:0 nt
  buffer_load_dwordx4 a[52:55], v61, s[64:67], s71 offen offset:1024 nt
  buffer_load_dwordx4 a[56:59], v61, s[64:67], s71 offen offset:2048 nt
  buffer_load_dwordx4 a[60:63], v61, s[64:67], s71 offen offset:3072 nt
  v_add_f32_dpp v44, v45, v44 row_ror:12 row_mask:0xf bank_mask:0xf
  v_add_f32_dpp v46, v47, v46 row_ror:12 row_mask:0xf bank_mask:0xf
  v_add_f32_dpp v49, v50, v49 row_ror:12 row_mask:0xf bank_mask:0xf
  v_add_f32_dpp v51, v48, v51 row_ror:12 row_mask:0xf bank_mask:0xf
  v_add_f32_dpp v54, v55, v54 row_ror:12 row_mask:0xf bank_mask:0xf
  v_add_f32_dpp v52, v53, v52 row_ror:12 row_mask:0xf bank_mask:0xf
  v_add_f32_dpp v59, v56, v59 row_ror:12 row_mask:0xf bank_mask:0xf
  v_add_f32_dpp v57, v58, v57 row_ror:12 row_mask:0xf bank_mask:0xf
  v_add_f32_dpp v87, v46, v44 row_ror:8 row_mask:0xf bank_mask:0x1
  s_nop 1
  v_add_f32_dpp v87, v51, v49 row_ror:8 row_mask:0xf bank_mask:0x2
  s_nop 1
  v_add_f32_dpp v87, v52, v54 row_ror:8 row_mask:0xf bank_mask:0x4
  s_nop 1
  v_add_f32_dpp v87, v57, v59 row_ror:8 row_mask:0xf bank_mask:0x8
  s_sub_u32 s74, s74, 1
  s_cmp_lg_u32 s74, 0
  s_cbranch_scc1 L_kl
  buffer_load_dword v28, v27, s[20:23], s47 offen sc1
  v_max_f32 v25, v64, v65
  v_max3_f32 v25, v25, v66, v67
  v_max3_f32 v25, v25, v68, v69
  v_max3_f32 v25, v25, v70, v71
  v_max3_f32 v25, v25, v72, v73
  v_max3_f32 v25, v25, v74, v75
  v_max3_f32 v25, v25, v76, v77
  v_max3_f32 v25, v25, v78, v79
  v_max3_f32 v25, v25, v80, v81
  v_max3_f32 v25, v25, v82, v83
  v_max3_f32 v25, v25, v84, v85
  v_max3_f32 v25, v25, v86, v87
  s_nop 1
  v_max_f32_dpp v23, v25, v25 row_ror:4 row_mask:0xf bank_mask:0xf
  s_nop 1
  v_max_f32_dpp v23, v23, v23 row_ror:8 row_mask:0xf bank_mask:0xf
  v_mov_b32 v24, v23
  s_nop 1
  v_permlane16_swap_b32 v24, v23
  v_max_f32 v23, v24, v23
  v_mov_b32 v24, v23
  s_nop 1
  v_permlane32_swap_b32 v24, v23
  v_max_f32 v23, v24, v23
  v_mul_f32 v23, s39, v23
  v_min_f32 v20, v23, v20
  s_mov_b32 s74, 6
L_vl:
  s_add_u32 s73, s73, 0x10000
  s_add_u32 s68, s73, 0
  s_add_u32 s69, s73, 16384
  s_add_u32 s70, s73, 32768
  s_add_u32 s71, s73, 49152
  s_cmp_lg_u32 s74, 1
  s_cbranch_scc1 L_vl1
  s_mov_b64 s[60:61], s[4:5]
  v_mov_b32 v60, v1
  s_mov_b32 s68, s32
  s_mov_b32 s69, s32
  s_add_u32 s70, s32, 0x4000
  s_add_u32 s71, s32, 0x4000
L_vl1:
  v_fma_f32 v33, v64, s38, v20
  v_exp_f32 v33, v33
  s_nop 0
  v_cvt_pk_bf16_f32 v34, v33, 0
  v_cvt_pk_bf16_f32 v35, 0, v33
  v_add_f32 v21, v21, v33
  v_mov_b32_dpp v36, v34 quad_perm:[0,1,2,3] row_mask:0xf bank_mask:0x1
  v_mov_b32_dpp v38, v34 row_ror:12 row_mask:0xf bank_mask:0x1
  v_mov_b32_dpp v40, v34 row_ror:8 row_mask:0xf bank_mask:0x1
  v_mov_b32_dpp v42, v34 row_ror:4 row_mask:0xf bank_mask:0x1
  v_mov_b32_dpp v36, v35 row_ror:4 row_mask:0xf bank_mask:0x2
  v_mov_b32_dpp v38, v35 quad_perm:[0,1,2,3] row_mask:0xf bank_mask:0x2
  v_mov_b32_dpp v40, v35 row_ror:12 row_mask:0xf bank_mask:0x2
  v_mov_b32_dpp v42, v35 row_ror:8 row_mask:0xf bank_mask:0x2
  v_mov_b32_dpp v37, v34 row_ror:8 row_mask:0xf bank_mask:0x4
  v_mov_b32_dpp v39, v34 row_ror:4 row_mask:0xf bank_mask:0x4
  v_mov_b32_dpp v41, v34 quad_perm:[0,1,2,3] row_mask:0xf bank_mask:0x4
  v_mov_b32_dpp v43, v34 row_ror:12 row_mask:0xf bank_mask:0x4
  v_mov_b32_dpp v37, v35 row_ror:12 row_mask:0xf bank_mask:0x8
  v_mov_b32_dpp v39, v35 row_ror:8 row_mask:0xf bank_mask:0x8
  v_mov_b32_dpp v41, v35 row_ror:4 row_mask:0xf bank_mask:0x8
  v_mov_b32_dpp v43, v35 quad_perm:[0,1,2,3] row_mask:0xf bank_mask:0x8
  s_waitcnt vmcnt(12)
  v_mfma_f32_16x16x16_bf16 v[12:15], v[36:37], a[0:1], v[12:15]
  v_mfma_f32_16x16x16_bf16 v[16:19], v[36:37], a[2:3], v[16:19]
  v_mfma_f32_16x16x16_bf16 v[12:15], v[38:39], a[4:5], v[12:15]
  v_mfma_f32_16x16x16_bf16 v[16:19], v[38:39], a[6:7], v[16:19]
  v_mfma_f32_16x16x16_bf16 v[12:15], v[40:41], a[8:9], v[12:15]
  v_mfma_f32_16x16x16_bf16 v[16:19], v[40:41], a[10:11], v[16:19]
  v_mfma_f32_16x16x16_bf16 v[12:15], v[42:43], a[12:13], v[12:15]
  v_mfma_f32_16x16x16_bf16 v[16:19], v[42:43], a[14:15], v[16:19]
  s_barrier
  buffer_load_dwordx4 a[0:3], v60, s[60:63], s68 offen offset:0 nt
  buffer_load_dwordx4 a[4:7], v60, s[60:63], s68 offen offset:1024 nt
  buffer_load_dwordx4 a[8:11], v60, s[60:63], s68 offen offset:2048 nt
  buffer_load_dwordx4 a[12:15], v60, s[60:63], s68 offen offset:3072 nt
  v_fma_f32 v33, v65, s38, v20
  v_exp_f32 v33, v33
  s_nop 0
  v_cvt_pk_bf16_f32 v34, v33, 0
  v_cvt_pk_bf16_f32 v35, 0, v33
  v_add_f32 v21, v21, v33
  v_mov_b32_dpp v36, v34 quad_perm:[0,1,2,3] row_mask:0xf bank_mask:0x1
  v_mov_b32_dpp v38, v34 row_ror:12 row_mask:0xf bank_mask:0x1
  v_mov_b32_dpp v40, v34 row_ror:8 row_mask:0xf bank_mask:0x1
  v_mov_b32_dpp v42, v34 row_ror:4 row_mask:0xf bank_mask:0x1
  v_mov_b32_dpp v36, v35 row_ror:4 row_mask:0xf bank_mask:0x2
  v_mov_b32_dpp v38, v35 quad_perm:[0,1,2,3] row_mask:0xf bank_mask:0x2
  v_mov_b32_dpp v40, v35 row_ror:12 row_mask:0xf bank_mask:0x2
  v_mov_b32_dpp v42, v35 row_ror:8 row_mask:0xf bank_mask:0x2
  v_mov_b32_dpp v37, v34 row_ror:8 row_mask:0xf bank_mask:0x4
  v_mov_b32_dpp v39, v34 row_ror:4 row_mask:0xf bank_mask:0x4
  v_mov_b32_dpp v41, v34 quad_perm:[0,1,2,3] row_mask:0xf bank_mask:0x4
  v_mov_b32_dpp v43, v34 row_ror:12 row_mask:0xf bank_mask:0x4
  v_mov_b32_dpp v37, v35 row_ror:12 row_mask:0xf bank_mask:0x8
  v_mov_b32_dpp v39, v35 row_ror:8 row_mask:0xf bank_mask:0x8
  v_mov_b32_dpp v41, v35 row_ror:4 row_mask:0xf bank_mask:0x8
  v_mov_b32_dpp v43, v35 quad_perm:[0,1,2,3] row_mask:0xf bank_mask:0x8
  s_waitcnt vmcnt(12)
  v_mfma_f32_16x16x16_bf16 v[12:15], v[36:37], a[16:17], v[12:15]
  v_mfma_f32_16x16x16_bf16 v[16:19], v[36:37], a[18:19], v[16:19]
  v_mfma_f32_16x16x16_bf16 v[12:15], v[38:39], a[20:21], v[12:15]
  v_mfma_f32_16x16x16_bf16 v[16:19], v[38:39], a[22:23], v[16:19]
  v_mfma_f32_16x16x16_bf16 v[12:15], v[40:41], a[24:25], v[12:15]
  v_mfma_f32_16x16x16_bf16 v[16:19], v[40:41], a[26:27], v[16:19]
  v_mfma_f32_16x16x16_bf16 v[12:15], v[42:43], a[28:29], v[12:15]
  v_mfma_f32_16x16x16_bf16 v[16:19], v[42:43], a[30:31], v[16:19]
  s_barrier
  buffer_load_dwordx4 a[16:19], v61, s[64:67], s69 offen offset:0 nt
  buffer_load_dwordx4 a[20:23], v61, s[64:67], s69 offen offset:1024 nt
  buffer_load_dwordx4 a[24:27], v61, s[64:67], s69 offen offset:2048 nt
  buffer_load_dwordx4 a[28:31], v61, s[64:67], s69 offen offset:3072 nt
  v_fma_f32 v33, v66, s38, v20
  v_exp_f32 v33, v33
  s_nop 0
  v_cvt_pk_bf16_f32 v34, v33, 0
  v_cvt_pk_bf16_f32 v35, 0, v33
  v_add_f32 v21, v21, v33
  v_mov_b32_dpp v36, v34 quad_perm:[0,1,2,3] row_mask:0xf bank_mask:0x1
  v_mov_b32_dpp v38, v34 row_ror:12 row_mask:0xf bank_mask:0x1
  v_mov_b32_dpp v40, v34 row_ror:8 row_mask:0xf bank_mask:0x1
  v_mov_b32_dpp v42, v34 row_ror:4 row_mask:0xf bank_mask:0x1
  v_mov_b32_dpp v36, v35 row_ror:4 row_mask:0xf bank_mask:0x2
  v_mov_b32_dpp v38, v35 quad_perm:[0,1,2,3] row_mask:0xf bank_mask:0x2
  v_mov_b32_dpp v40, v35 row_ror:12 row_mask:0xf bank_mask:0x2
  v_mov_b32_dpp v42, v35 row_ror:8 row_mask:0xf bank_mask:0x2
  v_mov_b32_dpp v37, v34 row_ror:8 row_mask:0xf bank_mask:0x4
  v_mov_b32_dpp v39, v34 row_ror:4 row_mask:0xf bank_mask:0x4
  v_mov_b32_dpp v41, v34 quad_perm:[0,1,2,3] row_mask:0xf bank_mask:0x4
  v_mov_b32_dpp v43, v34 row_ror:12 row_mask:0xf bank_mask:0x4
  v_mov_b32_dpp v37, v35 row_ror:12 row_mask:0xf bank_mask:0x8
  v_mov_b32_dpp v39, v35 row_ror:8 row_mask:0xf bank_mask:0x8
  v_mov_b32_dpp v41, v35 row_ror:4 row_mask:0xf bank_mask:0x8
  v_mov_b32_dpp v43, v35 quad_perm:[0,1,2,3] row_mask:0xf bank_mask:0x8
  s_waitcnt vmcnt(12)
  v_mfma_f32_16x16x16_bf16 v[12:15], v[36:37], a[32:33], v[12:15]
  v_mfma_f32_16x16x16_bf16 v[16:19], v[36:37], a[34:35], v[16:19]
  v_mfma_f32_16x16x16_bf16 v[12:15], v[38:39], a[36:37], v[12:15]
  v_mfma_f32_16x16x16_bf16 v[16:19], v[38:39], a[38:39], v[16:19]
  v_mfma_f32_16x16x16_bf16 v[12:15], v[40:41], a[40:41], v[12:15]
  v_mfma_f32_16x16x16_bf16 v[16:19], v[40:41], a[42:43], v[16:19]
  v_mfma_f32_16x16x16_bf16 v[12:15], v[42:43], a[44:45], v[12:15]
  v_mfma_f32_16x16x16_bf16 v[16:19], v[42:43], a[46:47], v[16:19]
  s_barrier
  buffer_load_dwordx4 a[32:35], v60, s[60:63], s70 offen offset:0 nt
  buffer_load_dwordx4 a[36:39], v60, s[60:63], s70 offen offset:1024 nt
  buffer_load_dwordx4 a[40:43], v60, s[60:63], s70 offen offset:2048 nt
  buffer_load_dwordx4 a[44:47], v60, s[60:63], s70 offen offset:3072 nt
  v_fma_f32 v33, v67, s38, v20
  v_exp_f32 v33, v33
  s_nop 0
  v_cvt_pk_bf16_f32 v34, v33, 0
  v_cvt_pk_bf16_f32 v35, 0, v33
  v_add_f32 v21, v21, v33
  v_mov_b32_dpp v36, v34 quad_perm:[0,1,2,3] row_mask:0xf bank_mask:0x1
  v_mov_b32_dpp v38, v34 row_ror:12 row_mask:0xf bank_mask:0x1
  v_mov_b32_dpp v40, v34 row_ror:8 row_mask:0xf bank_mask:0x1
  v_mov_b32_dpp v42, v34 row_ror:4 row_mask:0xf bank_mask:0x1
  v_mov_b32_dpp v36, v35 row_ror:4 row_mask:0xf bank_mask:0x2
  v_mov_b32_dpp v38, v35 quad_perm:[0,1,2,3] row_mask:0xf bank_mask:0x2
  v_mov_b32_dpp v40, v35 row_ror:12 row_mask:0xf bank_mask:0x2
  v_mov_b32_dpp v42, v35 row_ror:8 row_mask:0xf bank_mask:0x2
  v_mov_b32_dpp v37, v34 row_ror:8 row_mask:0xf bank_mask:0x4
  v_mov_b32_dpp v39, v34 row_ror:4 row_mask:0xf bank_mask:0x4
  v_mov_b32_dpp v41, v34 quad_perm:[0,1,2,3] row_mask:0xf bank_mask:0x4
  v_mov_b32_dpp v43, v34 row_ror:12 row_mask:0xf bank_mask:0x4
  v_mov_b32_dpp v37, v35 row_ror:12 row_mask:0xf bank_mask:0x8
  v_mov_b32_dpp v39, v35 row_ror:8 row_mask:0xf bank_mask:0x8
  v_mov_b32_dpp v41, v35 row_ror:4 row_mask:0xf bank_mask:0x8
  v_mov_b32_dpp v43, v35 quad_perm:[0,1,2,3] row_mask:0xf bank_mask:0x8
  s_waitcnt vmcnt(12)
  v_mfma_f32_16x16x16_bf16 v[12:15], v[36:37], a[48:49], v[12:15]
  v_mfma_f32_16x16x16_bf16 v[16:19], v[36:37], a[50:51], v[16:19]
  v_mfma_f32_16x16x16_bf16 v[12:15], v[38:39], a[52:53], v[12:15]
  v_mfma_f32_16x16x16_bf16 v[16:19], v[38:39], a[54:55], v[16:19]
  v_mfma_f32_16x16x16_bf16 v[12:15], v[40:41], a[56:57], v[12:15]
  v_mfma_f32_16x16x16_bf16 v[16:19], v[40:41], a[58:59], v[16:19]
  v_mfma_f32_16x16x16_bf16 v[12:15], v[42:43], a[60:61], v[12:15]
  v_mfma_f32_16x16x16_bf16 v[16:19], v[42:43], a[62:63], v[16:19]
  s_barrier
  buffer_load_dwordx4 a[48:51], v61, s[64:67], s71 offen offset:0 nt
  buffer_load_dwordx4 a[52:55], v61, s[64:67], s71 offen offset:1024 nt
  buffer_load_dwordx4 a[56:59], v61, s[64:67], s71 offen offset:2048 nt
  buffer_load_dwordx4 a[60:63], v61, s[64:67], s71 offen offset:3072 nt
  v_mov_b32 v64, v68
  v_mov_b32 v65, v69
  v_mov_b32 v66, v70
  v_mov_b32 v67, v71
  v_mov_b32 v68, v72
  v_mov_b32 v69, v73
  v_mov_b32 v70, v74
  v_mov_b32 v71, v75
  v_mov_b32 v72, v76
  v_mov_b32 v73, v77
  v_mov_b32 v74, v78
  v_mov_b32 v75, v79
  v_mov_b32 v76, v80
  v_mov_b32 v77, v81
  v_mov_b32 v78, v82
  v_mov_b32 v79, v83
  v_mov_b32 v80, v84
  v_mov_b32 v81, v85
  v_mov_b32 v82, v86
  v_mov_b32 v83, v87
  s_sub_u32 s74, s74, 1
  s_cmp_lg_u32 s74, 0
  s_cbranch_scc1 L_vl
L_iter:
  ds_read_b64 v[30:31], v3 offset:128
  s_waitcnt vmcnt(12)
  v_mfma_f32_16x16x32_bf16 v[44:47], a[0:3], v[8:11], 0
  v_mfma_f32_16x16x32_bf16 v[48:51], a[4:7], v[8:11], 0
  v_mfma_f32_16x16x32_bf16 v[52:55], a[8:11], v[8:11], 0
  v_mfma_f32_16x16x32_bf16 v[56:59], a[12:15], v[8:11], 0
  s_add_u32 s30, s30, 4
  s_add_u32 s36, s33, 1
  s_cmp_ge_u32 s36, s40
  s_cbranch_scc1 L_dyn
L_unit:
  s_and_b32 s36, s30, 3
  s_andn2_b32 s37, s30, 3
  s_lshl1_add_u32 s36, s37, s36
  s_lshl_b32 s32, s36, 12
  s_add_u32 s32, s32, 786432
  s_barrier
  buffer_load_dwordx4 a[0:3], v1, s[4:7], s32 offen offset:0 nt
  buffer_load_dwordx4 a[4:7], v1, s[4:7], s32 offen offset:1024 nt
  buffer_load_dwordx4 a[8:11], v1, s[4:7], s32 offen offset:2048 nt
  buffer_load_dwordx4 a[12:15], v1, s[4:7], s32 offen offset:3072 nt
  v_add_f32_dpp v44, v45, v44 row_ror:12 row_mask:0xf bank_mask:0xf
  v_add_f32_dpp v46, v47, v46 row_ror:12 row_mask:0xf bank_mask:0xf
  v_add_f32_dpp v49, v50, v49 row_ror:12 row_mask:0xf bank_mask:0xf
  v_add_f32_dpp v51, v48, v51 row_ror:12 row_mask:0xf bank_mask:0xf
  v_add_f32_dpp v54, v55, v54 row_ror:12 row_mask:0xf bank_mask:0xf
  v_add_f32_dpp v52, v53, v52 row_ror:12 row_mask:0xf bank_mask:0xf
  v_add_f32_dpp v59, v56, v59 row_ror:12 row_mask:0xf bank_mask:0xf
  v_add_f32_dpp v57, v58, v57 row_ror:12 row_mask:0xf bank_mask:0xf
  v_add_f32_dpp v32, v46, v44 row_ror:8 row_mask:0xf bank_mask:0x1
  s_nop 1
  v_add_f32_dpp v32, v51, v49 row_ror:8 row_mask:0xf bank_mask:0x2
  s_nop 1
  v_add_f32_dpp v32, v52, v54 row_ror:8 row_mask:0xf bank_mask:0x4
  s_nop 1
  v_add_f32_dpp v32, v57, v59 row_ror:8 row_mask:0xf bank_mask:0x8
  s_nop 1
  v_max_f32_dpp v23, v32, v32 row_ror:4 row_mask:0xf bank_mask:0xf
  s_nop 1
  v_max_f32_dpp v23, v23, v23 row_ror:8 row_mask:0xf bank_mask:0xf
  v_mov_b32 v24, v23
  s_nop 1
  v_permlane16_swap_b32 v24, v23
  v_max_f32 v23, v24, v23
  v_mov_b32 v24, v23
  s_nop 1
  v_permlane32_swap_b32 v24, v23
  v_max_f32 v23, v24, v23
  v_mul_f32 v23, s39, v23
  v_min_f32 v23, v23, v20
  v_sub_f32 v25, v23, v20
  v_fma_f32 v33, v32, s38, v23
  v_exp_f32 v22, v25
  v_exp_f32 v33, v33
  v_mov_b32 v20, v23
  v_cvt_pk_bf16_f32 v34, v33, 0
  v_cvt_pk_bf16_f32 v35, 0, v33
  v_fma_f32 v21, v21, v22, v33
  v_mul_f32_dpp v12, v22, v12 quad_perm:[0,0,0,0] row_mask:0xf bank_mask:0xf
  v_mul_f32_dpp v16, v22, v16 quad_perm:[0,0,0,0] row_mask:0xf bank_mask:0xf
  v_mul_f32_dpp v13, v22, v13 quad_perm:[1,1,1,1] row_mask:0xf bank_mask:0xf
  v_mul_f32_dpp v17, v22, v17 quad_perm:[1,1,1,1] row_mask:0xf bank_mask:0xf
  v_mul_f32_dpp v14, v22, v14 quad_perm:[2,2,2,2] row_mask:0xf bank_mask:0xf
  v_mul_f32_dpp v18, v22, v18 quad_perm:[2,2,2,2] row_mask:0xf bank_mask:0xf
  v_mul_f32_dpp v15, v22, v15 quad_perm:[3,3,3,3] row_mask:0xf bank_mask:0xf
  v_mul_f32_dpp v19, v22, v19 quad_perm:[3,3,3,3] row_mask:0xf bank_mask:0xf
  v_mov_b32_dpp v36, v34 quad_perm:[0,1,2,3] row_mask:0xf bank_mask:0x1
  v_mov_b32_dpp v38, v34 row_ror:12 row_mask:0xf bank_mask:0x1
  v_mov_b32_dpp v40, v34 row_ror:8 row_mask:0xf bank_mask:0x1
  v_mov_b32_dpp v42, v34 row_ror:4 row_mask:0xf bank_mask:0x1
  v_mov_b32_dpp v36, v35 row_ror:4 row_mask:0xf bank_mask:0x2
  v_mov_b32_dpp v38, v35 quad_perm:[0,1,2,3] row_mask:0xf bank_mask:0x2
  v_mov_b32_dpp v40, v35 row_ror:12 row_mask:0xf bank_mask:0x2
  v_mov_b32_dpp v42, v35 row_ror:8 row_mask:0xf bank_mask:0x2
  v_mov_b32_dpp v37, v34 row_ror:8 row_mask:0xf bank_mask:0x4
  v_mov_b32_dpp v39, v34 row_ror:4 row_mask:0xf bank_mask:0x4
  v_mov_b32_dpp v41, v34 quad_perm:[0,1,2,3] row_mask:0xf bank_mask:0x4
  v_mov_b32_dpp v43, v34 row_ror:12 row_mask:0xf bank_mask:0x4
  v_mov_b32_dpp v37, v35 row_ror:12 row_mask:0xf bank_mask:0x8
  v_mov_b32_dpp v39, v35 row_ror:8 row_mask:0xf bank_mask:0x8
  v_mov_b32_dpp v41, v35 row_ror:4 row_mask:0xf bank_mask:0x8
  v_mov_b32_dpp v43, v35 quad_perm:[0,1,2,3] row_mask:0xf bank_mask:0x8
  s_waitcnt vmcnt(12)
  v_mfma_f32_16x16x16_bf16 v[12:15], v[36:37], a[16:17], v[12:15]
  v_mfma_f32_16x16x16_bf16 v[16:19], v[36:37], a[18:19], v[16:19]
  v_mfma_f32_16x16x16_bf16 v[12:15], v[38:39], a[20:21], v[12:15]
  v_mfma_f32_16x16x16_bf16 v[16:19], v[38:39], a[22:23], v[16:19]
  v_mfma_f32_16x16x16_bf16 v[12:15], v[40:41], a[24:25], v[12:15]
  v_mfma_f32_16x16x16_bf16 v[16:19], v[40:41], a[26:27], v[16:19]
  v_mfma_f32_16x16x16_bf16 v[12:15], v[42:43], a[28:29], v[12:15]
  v_mfma_f32_16x16x16_bf16 v[16:19], v[42:43], a[30:31], v[16:19]
  s_barrier
  buffer_load_dwordx4 a[16:19], v2, s[8:11], s32 offen offset:0 nt
  buffer_load_dwordx4 a[20:23], v2, s[8:11], s32 offen offset:1024 nt
  buffer_load_dwordx4 a[24:27], v2, s[8:11], s32 offen offset:2048 nt
  buffer_load_dwordx4 a[28:31], v2, s[8:11], s32 offen offset:3072 nt
  s_mov_b32 s31, 2
  s_add_u32 s36, s33, 2
  s_cmp_lt_u32 s36, s40
  s_cbranch_scc1 L_noel
  s_cmp_ge_u32 s30, 32
  s_cbranch_scc1 L_noel
  s_mov_b32 s31, 0
  s_mov_b64 exec, 1
  ds_add_rtn_u32 v29, v3, v4
  s_mov_b64 exec, -1
L_noel:
  s_waitcnt vmcnt(12)
  v_mfma_f32_16x16x32_bf16 v[44:47], a[32:35], v[8:11], 0
  v_mfma_f32_16x16x32_bf16 v[48:51], a[36:39], v[8:11], 0
  v_mfma_f32_16x16x32_bf16 v[52:55], a[40:43], v[8:11], 0
  v_mfma_f32_16x16x32_bf16 v[56:59], a[44:47], v[8:11], 0
  s_add_u32 s32, s32, 0x4000
  s_barrier
  buffer_load_dwordx4 a[32:35], v1, s[4:7], s32 offen offset:0 nt
  buffer_load_dwordx4 a[36:39], v1, s[4:7], s32 offen offset:1024 nt
  buffer_load_dwordx4 a[40:43], v1, s[4:7], s32 offen offset:2048 nt
  buffer_load_dwordx4 a[44:47], v1, s[4:7], s32 offen offset:3072 nt
  s_cmp_lg_u32 s31, 0
  s_cbranch_scc1 L_notk
  s_waitcnt lgkmcnt(0)
  v_readfirstlane_b32 s36, v29
  s_nop 1
  s_cmp_lg_u32 s36, 0
  s_cbranch_scc1 L_notk
  s_add_u32 s36, s33, 2
  s_cmp_eq_u32 s36, s40
  s_cbranch_scc1 L_chk
L_tk:
  s_mov_b32 s31, 1
  s_mov_b64 s[34:35], 4
  s_atomic_add_x2 s[34:35], s[42:43], 0 glc
L_notk:
  v_add_f32_dpp v44, v45, v44 row_ror:12 row_mask:0xf bank_mask:0xf
  v_add_f32_dpp v46, v47, v46 row_ror:12 row_mask:0xf bank_mask:0xf
  v_add_f32_dpp v49, v50, v49 row_ror:12 row_mask:0xf bank_mask:0xf
  v_add_f32_dpp v51, v48, v51 row_ror:12 row_mask:0xf bank_mask:0xf
  v_add_f32_dpp v54, v55, v54 row_ror:12 row_mask:0xf bank_mask:0xf
  v_add_f32_dpp v52, v53, v52 row_ror:12 row_mask:0xf bank_mask:0xf
  v_add_f32_dpp v59, v56, v59 row_ror:12 row_mask:0xf bank_mask:0xf
  v_add_f32_dpp v57, v58, v57 row_ror:12 row_mask:0xf bank_mask:0xf
  v_add_f32_dpp v32, v46, v44 row_ror:8 row_mask:0xf bank_mask:0x1
  s_nop 1
  v_add_f32_dpp v32, v51, v49 row_ror:8 row_mask:0xf bank_mask:0x2
  s_nop 1
  v_add_f32_dpp v32, v52, v54 row_ror:8 row_mask:0xf bank_mask:0x4
  s_nop 1
  v_add_f32_dpp v32, v57, v59 row_ror:8 row_mask:0xf bank_mask:0x8
  s_nop 1
  v_max_f32_dpp v23, v32, v32 row_ror:4 row_mask:0xf bank_mask:0xf
  s_nop 1
  v_max_f32_dpp v23, v23, v23 row_ror:8 row_mask:0xf bank_mask:0xf
  v_mov_b32 v24, v23
  s_nop 1
  v_permlane16_swap_b32 v24, v23
  v_max_f32 v23, v24, v23
  v_mov_b32 v24, v23
  s_nop 1
  v_permlane32_swap_b32 v24, v23
  v_max_f32 v23, v24, v23
  v_mul_f32 v23, s39, v23
  v_min_f32 v23, v23, v20
  v_sub_f32 v25, v23, v20
  v_fma_f32 v33, v32, s38, v23
  v_exp_f32 v22, v25
  v_exp_f32 v33, v33
  v_mov_b32 v20, v23
  v_cvt_pk_bf16_f32 v34, v33, 0
  v_cvt_pk_bf16_f32 v35, 0, v33
  v_fma_f32 v21, v21, v22, v33
  v_mul_f32_dpp v12, v22, v12 quad_perm:[0,0,0,0] row_mask:0xf bank_mask:0xf
  v_mul_f32_dpp v16, v22, v16 quad_perm:[0,0,0,0] row_mask:0xf bank_mask:0xf
  v_mul_f32_dpp v13, v22, v13 quad_perm:[1,1,1,1] row_mask:0xf bank_mask:0xf
  v_mul_f32_dpp v17, v22, v17 quad_perm:[1,1,1,1] row_mask:0xf bank_mask:0xf
  v_mul_f32_dpp v14, v22, v14 quad_perm:[2,2,2,2] row_mask:0xf bank_mask:0xf
  v_mul_f32_dpp v18, v22, v18 quad_perm:[2,2,2,2] row_mask:0xf bank_mask:0xf
  v_mul_f32_dpp v15, v22, v15 quad_perm:[3,3,3,3] row_mask:0xf bank_mask:0xf
  v_mul_f32_dpp v19, v22, v19 quad_perm:[3,3,3,3] row_mask:0xf bank_mask:0xf
  v_mov_b32_dpp v36, v34 quad_perm:[0,1,2,3] row_mask:0xf bank_mask:0x1
  v_mov_b32_dpp v38, v34 row_ror:12 row_mask:0xf bank_mask:0x1
  v_mov_b32_dpp v40, v34 row_ror:8 row_mask:0xf bank_mask:0x1
  v_mov_b32_dpp v42, v34 row_ror:4 row_mask:0xf bank_mask:0x1
  v_mov_b32_dpp v36, v35 row_ror:4 row_mask:0xf bank_mask:0x2
  v_mov_b32_dpp v38, v35 quad_perm:[0,1,2,3] row_mask:0xf bank_mask:0x2
  v_mov_b32_dpp v40, v35 row_ror:12 row_mask:0xf bank_mask:0x2
  v_mov_b32_dpp v42, v35 row_ror:8 row_mask:0xf bank_mask:0x2
  v_mov_b32_dpp v37, v34 row_ror:8 row_mask:0xf bank_mask:0x4
  v_mov_b32_dpp v39, v34 row_ror:4 row_mask:0xf bank_mask:0x4
  v_mov_b32_dpp v41, v34 quad_perm:[0,1,2,3] row_mask:0xf bank_mask:0x4
  v_mov_b32_dpp v43, v34 row_ror:12 row_mask:0xf bank_mask:0x4
  v_mov_b32_dpp v37, v35 row_ror:12 row_mask:0xf bank_mask:0x8
  v_mov_b32_dpp v39, v35 row_ror:8 row_mask:0xf bank_mask:0x8
  v_mov_b32_dpp v41, v35 row_ror:4 row_mask:0xf bank_mask:0x8
  v_mov_b32_dpp v43, v35 quad_perm:[0,1,2,3] row_mask:0xf bank_mask:0x8
  s_waitcnt vmcnt(12)
  v_mfma_f32_16x16x16_bf16 v[12:15], v[36:37], a[48:49], v[12:15]
  v_mfma_f32_16x16x16_bf16 v[16:19], v[36:37], a[50:51], v[16:19]
  v_mfma_f32_16x16x16_bf16 v[12:15], v[38:39], a[52:53], v[12:15]
  v_mfma_f32_16x16x16_bf16 v[16:19], v[38:39], a[54:55], v[16:19]
  v_mfma_f32_16x16x16_bf16 v[12:15], v[40:41], a[56:57], v[12:15]
  v_mfma_f32_16x16x16_bf16 v[16:19], v[40:41], a[58:59], v[16:19]
  v_mfma_f32_16x16x16_bf16 v[12:15], v[42:43], a[60:61], v[12:15]
  v_mfma_f32_16x16x16_bf16 v[16:19], v[42:43], a[62:63], v[16:19]
  s_barrier
  buffer_load_dwordx4 a[48:51], v2, s[8:11], s32 offen offset:0 nt
  buffer_load_dwordx4 a[52:55], v2, s[8:11], s32 offen offset:1024 nt
  buffer_load_dwordx4 a[56:59], v2, s[8:11], s32 offen offset:2048 nt
  buffer_load_dwordx4 a[60:63], v2, s[8:11], s32 offen offset:3072 nt
L_next:
  s_add_u32 s33, s33, 1
  s_cmp_lt_u32 s30, 32
  s_cbranch_scc1 L_iter
  v_add_f32_dpp v21, v21, v21 row_ror:4 row_mask:0xf bank_mask:0xf
  v_and_b32 v5, 15, v26
  v_lshrrev_b32 v6, 4, v26
  v_add_f32_dpp v21, v21, v21 row_ror:8 row_mask:0xf bank_mask:0xf
  v_lshlrev_b32 v5, 5, v5
  v_lshl_add_u32 v5, v6, 2, v5
  s_lshl_b32 s36, s3, 11
  v_mov_b32 v24, v21
  v_add_u32 v5, s36, v5
  s_lshl_b32 s36, s3, 5
  v_permlane16_swap_b32 v24, v21
  ds_write_b32 v5, v12 offset:0
  ds_write_b32 v5, v16 offset:16
  ds_write_b32 v5, v13 offset:512
  ds_write_b32 v5, v17 offset:528
  ds_write_b32 v5, v14 offset:1024
  ds_write_b32 v5, v18 offset:1040
  ds_write_b32 v5, v15 offset:1536
  ds_write_b32 v5, v19 offset:1552
  v_add_f32 v21, v24, v21
  s_add_u32 s36, s36, 8192
  v_mov_b32 v24, v21
  v_lshlrev_b32 v6, 3, v7
  v_add_u32 v6, s36, v6
  v_permlane32_swap_b32 v24, v21
  v_add_f32 v21, v24, v21
  s_mov_b64 exec, 15
  ds_write_b64 v6, v[20:21]
  s_mov_b64 exec, -1
  s_lshl_b32 s36, s3, 9
  v_lshlrev_b32 v5, 3, v26
  v_add_u32 v5, s36, v5
  s_lshl_b32 s36, s3, 3
  s_add_u32 s36, s36, 8192
  v_mov_b32 v6, s36
  v_lshlrev_b32 v7, 4, v0
  v_mov_b32 v25, 0x2081cea
  s_cmp_lg_u32 s29, 1
  s_cbranch_scc1 L_nopre
  buffer_load_dwordx4 v[36:39], v7, s[24:27], s46 offen sc1
L_nopre:
  s_waitcnt lgkmcnt(0)
  s_barrier
  ds_read_b64 v[52:53], v6 offset:0
  ds_read_b64 v[54:55], v6 offset:32
  ds_read_b64 v[56:57], v6 offset:64
  ds_read_b64 v[58:59], v6 offset:96
  ds_read_b64 v[44:45], v5 offset:0
  ds_read_b64 v[46:47], v5 offset:2048
  ds_read_b64 v[48:49], v5 offset:4096
  ds_read_b64 v[50:51], v5 offset:6144
  s_waitcnt lgkmcnt(4)
  v_min_f32 v23, v52, v54
  v_min3_f32 v23, v23, v56, v58
  v_sub_f32 v52, v23, v52
  v_sub_f32 v54, v23, v54
  v_sub_f32 v56, v23, v56
  v_sub_f32 v58, v23, v58
  v_exp_f32 v52, v52
  v_exp_f32 v54, v54
  v_exp_f32 v56, v56
  v_exp_f32 v58, v58
  v_fma_f32 v22, v52, v53, v25
  v_fma_f32 v22, v54, v55, v22
  v_fma_f32 v22, v56, v57, v22
  v_fma_f32 v22, v58, v59, v22
  v_log_f32 v42, v22
  v_rcp_f32 v22, v22
  s_waitcnt lgkmcnt(0)
  v_mul_f32 v40, v52, v44
  v_mul_f32 v41, v52, v45
  v_fma_f32 v40, v54, v46, v40
  v_fma_f32 v41, v54, v47, v41
  v_fma_f32 v40, v56, v48, v40
  v_fma_f32 v41, v56, v49, v41
  v_fma_f32 v40, v58, v50, v40
  v_fma_f32 v41, v58, v51, v41
  v_sub_f32 v42, v42, v23
  v_mov_b32 v43, s35
  v_mul_f32 v40, v22, v40
  v_mul_f32 v41, v22, v41
  s_cmp_eq_u32 s29, 1
  s_cbranch_scc1 L_consumer
  buffer_store_dwordx4 v[40:43], v7, s[24:27], s46 offen sc1
  s_branch L_fin
L_dyn:
  s_waitcnt lgkmcnt(0)
  s_cmp_lg_u32 s31, 1
  s_cbranch_scc1 L_dyn1
  v_mov_b32 v30, s34
  v_mov_b32 v31, s35
  s_mov_b64 exec, 1
  ds_write_b64 v3, v[30:31] offset:128
  s_mov_b64 exec, -1
  s_branch L_dyn3
L_dyn1:
  s_mov_b32 s37, 0x1000000
L_dyn2:
  v_readfirstlane_b32 s34, v30
  v_readfirstlane_b32 s35, v31
  s_nop 0
  s_cmp_lg_u32 s34, 0
  s_cbranch_scc1 L_dyn3
  s_mov_b32 s34, 0x1000
  s_sub_u32 s37, s37, 1
  s_cbranch_scc1 L_dyn3
  ds_read_b64 v[30:31], v3 offset:128
  s_waitcnt lgkmcnt(0)
  s_branch L_dyn2
L_dyn3:
  s_add_u32 s30, s34, s3
  v_add_u32 v3, 8, v3
  s_branch L_unit
L_chk:
  s_mov_b32 s37, 0x100000
L_chk1:
  v_readfirstlane_b32 s36, v28
  s_nop 1
  s_and_b32 s36, s36, s48
  s_cbranch_scc1 L_tk
  s_sub_u32 s37, s37, 1
  s_cbranch_scc1 L_tk
  s_sleep 8
  buffer_load_dword v28, v27, s[20:23], s47 offen sc1
  s_waitcnt vmcnt(0)
  s_branch L_chk1
L_poll:
  buffer_load_dwordx4 v[36:39], v7, s[24:27], s46 offen sc1
L_consumer:
  s_sub_u32 s33, s33, 0x1000
  s_waitcnt vmcnt(0)
  v_cmp_ne_u32 vcc, s35, v39
  s_cmp_lt_u32 s33, 0x1000
  s_cbranch_scc1 L_got
  s_nop 2
  s_cbranch_vccnz L_poll
L_got:
  v_sub_f32 v23, v42, v38
  v_exp_f32 v23, v23
  v_sub_f32 v36, v36, v40
  v_sub_f32 v37, v37, v41
  v_lshlrev_b32 v5, 2, v0
  v_add_f32 v23, 1.0, v23
  v_rcp_f32 v23, v23
  s_nop 0
  v_fma_f32 v40, v23, v36, v40
  v_fma_f32 v41, v23, v37, v41
  v_cvt_pk_bf16_f32 v40, v40, v41
  buffer_store_dword v40, v5, s[16:19], s49 offen
L_fin:
L_end:
  s_endpgm
.section .rodata,"a"
.p2align 6
.amdhsa_kernel standalone__gqa_softmax__sampling_kernel
  .amdhsa_next_free_vgpr 152
  .amdhsa_next_free_sgpr 80
  .amdhsa_accum_offset 88
  .amdhsa_group_segment_fixed_size 0
  .amdhsa_kernarg_size 48
  .amdhsa_user_sgpr_count 2
  .amdhsa_user_sgpr_kernarg_segment_ptr 1
  .amdhsa_system_sgpr_workgroup_id_x 1
  .amdhsa_float_denorm_mode_32 3
.end_amdhsa_kernel
```
